```python
import torch

def _softmax(x, axis=-1):
    return torch.softmax(x, dim=axis)
def _gelu(x):
    return torch.nn.functional.gelu(x, approximate="tanh")
def _silu(x):
    return torch.nn.functional.silu(x)
def _sigmoid(x):
    return torch.sigmoid(x)
def _layernorm(x, axis=-1, eps=1e-5):
    m = x.mean(dim=axis, keepdim=True)
    v = x.var(dim=axis, keepdim=True, unbiased=False)
    return (x - m) / torch.sqrt(v + eps)
def _scatter_add(tgt, idx, src, axis=0):
    return tgt.clone().index_add_(axis, idx, src)
def _segment_sum(src, seg, n):
    out = torch.zeros((n,) + src.shape[1:], dtype=src.dtype)
    return out.index_add_(0, seg, src)
def _pad(x, pw):
    flat = tuple(v for pair in reversed(pw) for v in pair)
    return torch.nn.functional.pad(x, flat)

kernel_name = 'standalone__paged_block_table_kv_pagedattention__decode'

def setup_inputs():

    _w = (lambda a: (lambda t: t.to(torch.bfloat16) if t.is_floating_point() else t)(torch.as_tensor(a)))
    B, Hq, Hkv, Sq, Skv, D = 1, 32, 8, 1, 32768, 128
    bs = 16
    nbps = max(1, Skv // bs)
    num_phys = B * nbps + 4
    bt = torch.randperm(num_phys)[: B * nbps].reshape(B, nbps).to(torch.int64)
    cl = (nbps * bs - (torch.arange(1, B + 1, dtype=torch.int64) * 2654435761) % max(1, nbps * bs // 2)).to(torch.int64)
    return {
        "q": _w((lambda *s: torch.randn(*s, dtype=torch.bfloat16) * 0.8)(B, Hq, Sq, D)),
        "k_cache": _w((lambda *s: torch.randn(*s, dtype=torch.bfloat16) * 0.8)(num_phys, bs, Hkv, D)),
        "v_cache": _w((lambda *s: torch.randn(*s, dtype=torch.bfloat16) * 0.05)(num_phys, bs, Hkv, D)),
        "block_table": _w(bt),
        "context_lens": _w(cl),
    }

def reference(q, k_cache, v_cache, block_table, context_lens):
    B, Hq, Sq, D = q.shape
    bs = k_cache.shape[1]
    Hkv = k_cache.shape[2]
    nbps = block_table.shape[1]
    Skv = nbps * bs
    bt = block_table.reshape(-1)
    k = (lambda x, *d: x.permute(*d))(k_cache[bt].reshape(B, Skv, Hkv, D), 0, 2, 1, 3)
    v = (lambda x, *d: x.permute(*d))(v_cache[bt].reshape(B, Skv, Hkv, D), 0, 2, 1, 3)
    g = Hq // Hkv
    qg = q.reshape(B, Hkv, g, Sq, D)
    scores = torch.einsum("bhgqd,bhkd->bhgqk", qg, k) * (D ** -0.5)
    pos = torch.arange(Skv)
    msk = pos[None, :] < context_lens[:, None]
    scores = torch.where(msk[:, None, None, None, :], scores, -1e9)
    p = _softmax(scores, axis=-1)
    out = torch.einsum("bhgqk,bhkd->bhgqd", p, v)
    return out.reshape(B, Hq, Sq, D)
```

```asm
; @launch grid=(256,1,1) block=(512,1,1) lds=19712
.amdgcn_target "amdgcn-amd-amdhsa--gfx950"
.text
.globl standalone__paged_block_table_kv_pagedattention__decode_kernel
.p2align 8
.type standalone__paged_block_table_kv_pagedattention__decode_kernel,@function
standalone__paged_block_table_kv_pagedattention__decode_kernel:
    s_cmp_ge_u32 s2, 256
    s_cbranch_scc1 L_end
    s_load_dwordx16 s[4:19], s[0:1], 0
    v_lshrrev_b32 v22, 6, v0
    s_mov_b32 s43, 0xe800
    v_readfirstlane_b32 s39, v22
    s_mov_b32 s79, 0x11a7ba
    s_cmp_ge_u32 s2, 29
    s_cselect_b32 s43, 0x138e9, s43
    s_cselect_b32 s79, 0xd20d3, s79
    s_cmp_ge_u32 s2, 68
    s_cselect_b32 s43, 0xea22, s43
    s_cselect_b32 s79, 0x11a7ba, s79
    s_cmp_ge_u32 s2, 97
    s_cselect_b32 s43, 0xeb0b, s43
    s_cselect_b32 s79, 0x11a7ba, s79
    s_cmp_ge_u32 s2, 126
    s_cselect_b32 s43, 0xebf4, s43
    s_cselect_b32 s79, 0x11a7ba, s79
    s_cmp_ge_u32 s2, 155
    s_cselect_b32 s43, 0x13cdd, s43
    s_cselect_b32 s79, 0xd20d3, s79
    s_cmp_ge_u32 s2, 194
    s_cselect_b32 s43, 0xee16, s43
    s_cselect_b32 s79, 0x11a7ba, s79
    s_cmp_ge_u32 s2, 223
    s_cselect_b32 s43, 0x10eff, s43
    s_cselect_b32 s79, 0xf83e1, s79
    s_lshr_b32 s75, s43, 11
    s_bfe_u32 s76, s43, 0x80003
    s_and_b32 s67, s43, 7
    s_sub_u32 s38, s2, s76
    s_mul_i32 s40, s39, s75
    s_add_u32 s40, s40, s38
    s_lshl_b32 s45, s75, 3
    s_lshl_b32 s44, s75, 5
    s_lshl_b32 s80, s40, 2
    s_add_u32 s43, s80, s44
    s_min_u32 s81, s43, 0x1ffc
    s_add_u32 s43, s43, s44
    s_min_u32 s82, s43, 0x1ffc
    s_add_u32 s43, s43, s44
    s_min_u32 s83, s43, 0x1ffc
    s_add_u32 s43, s43, s44
    s_min_u32 s84, s43, 0x1ffc
    s_add_u32 s43, s43, s44
    s_min_u32 s85, s43, 0x1ffc
    s_add_u32 s43, s43, s44
    s_min_u32 s86, s43, 0x1ffc
    s_add_u32 s43, s43, s44
    s_min_u32 s87, s43, 0x1ffc
    s_add_u32 s43, s43, s44
    s_min_u32 s88, s43, 0x1ffc
    s_waitcnt lgkmcnt(0)
    s_load_dword s66, s[12:13], 0
    s_load_dword s28, s[10:11], s80
    s_load_dword s29, s[10:11], s81
    s_load_dword s30, s[10:11], s82
    s_load_dword s31, s[10:11], s83
    s_load_dword s32, s[10:11], s84
    s_load_dword s33, s[10:11], s85
    s_load_dword s34, s[10:11], s86
    s_load_dword s35, s[10:11], s87
    s_load_dword s36, s[10:11], s88
    v_and_b32 v1, 63, v0
    s_lshl_b32 s44, s67, 10
    v_lshrrev_b32 v18, 4, v1
    v_bfe_u32 v22, v1, 2, 2
    v_and_b32 v23, 3, v1
    v_lshlrev_b32 v24, 4, v23
    v_lshl_add_u32 v24, v18, 6, v24
    v_lshl_add_u32 v26, v22, 8, v24
    v_add_u32 v26, s44, v26
    global_load_dwordx4 v[12:15], v26, s[4:5]
    s_lshl_b32 s44, s67, 8
    v_lshl_add_u32 v2, v22, 11, v24
    v_add_u32 v2, s44, v2
    v_add_u32 v3, 0x2000, v2
    v_add_u32 v4, 0x4000, v2
    v_add_u32 v5, 0x6000, v2
    v_and_b32 v25, 15, v1
    v_lshlrev_b32 v25, 4, v25
    v_lshl_add_u32 v6, v18, 11, v25
    v_add_u32 v6, s44, v6
    v_add_u32 v7, 0x2000, v6
    v_add_u32 v8, 0x4000, v6
    v_add_u32 v9, 0x6000, v6
    s_mov_b32 s20, s6
    s_mov_b32 s21, s7
    s_mov_b32 s22, 67239936
    s_mov_b32 s23, 0x00020000
    s_mov_b32 s24, s8
    s_mov_b32 s25, s9
    s_mov_b32 s26, 67239936
    s_mov_b32 s27, 0x00020000
    v_and_b32 v24, 1, v23
    v_lshlrev_b32 v24, 4, v24
    v_mov_b32 v25, 0xffff
    v_lshlrev_b32 v25, v24, v25
    v_cmp_gt_u32 vcc, 2, v23
    v_mov_b32 v17, 0xff800000
    v_mov_b32 v20, 0xff7fffff
    v_mov_b32 v21, 0
    v_cndmask_b32 v10, 0, v25, vcc
    v_cndmask_b32_e64 v11, v25, 0, vcc
    s_lshl_b32 s77, s75, 7
    s_lshl_b32 s43, s40, 4
    s_sub_u32 s90, s77, s43
    s_sub_u32 s90, s90, 1
    s_mov_b32 s91, 0x3e0293ee
    s_mul_i32 s43, s39, 2432
    v_mul_u32_u24 v32, 152, v22
    v_mul_u32_u24 v33, 36, v18
    v_add3_u32 v32, v32, v33, v23
    v_lshl_add_u32 v128, v32, 2, s43
    s_lshl_b32 s44, s39, 3
    s_add_u32 s44, s44, 19456
    v_lshl_add_u32 v129, v22, 6, s44
    s_lshr_b32 s92, s39, 1
    s_and_b32 s93, s39, 1
    s_mul_i32 s43, s92, 608
    s_mul_i32 s44, s93, 288
    s_add_u32 s43, s43, s44
    v_bfe_u32 v34, v1, 3, 1
    v_and_b32 v35, 7, v1
    v_mul_u32_u24 v34, 144, v34
    v_lshl_add_u32 v34, v35, 4, v34
    v_add_u32 v130, s43, v34
    s_lshl_b32 s43, s92, 6
    s_add_u32 s43, s43, 19456
    v_mov_b32 v131, s43
    s_lshl_b32 s43, s2, 10
    s_lshl_b32 s44, s39, 7
    s_add_u32 s43, s43, s44
    v_lshl_add_u32 v132, v1, 3, s43
    s_lshl_b32 s43, s92, 3
    s_add_u32 s43, s43, s67
    s_lshl_b32 s43, s43, 9
    s_add_u32 s78, s43, 524288
    s_lshl_b32 s44, s38, 3
    s_add_u32 s43, s78, s44
    v_mov_b32 v133, s43
    v_mov_b32 v24, 0
    v_mov_b32 v25, 0
    v_mov_b32 v26, 0
    v_mov_b32 v27, 0
    v_mov_b32 v28, 0
    v_mov_b32 v29, 0
    v_mov_b32 v30, 0
    v_mov_b32 v31, 0
    s_waitcnt lgkmcnt(0)
    s_cmp_lt_i32 s66, 1
    s_cselect_b32 s66, 0x8000, s66
    s_cselect_b32 s91, 0, s91
    s_min_i32 s66, s66, 0x8000
    s_add_i32 s44, s66, s90
    s_max_i32 s44, s44, 0
    s_mul_hi_u32 s44, s44, s79
    s_sub_u32 s41, 9, s44
    s_lshl_b32 s43, s40, 4
    s_sub_i32 s42, s66, s43
    v_mov_b32 v16, s91
    s_cmp_ge_u32 s41, 4
    s_cbranch_scc1 L_pl_4
L_pl_0:
    s_cmp_lg_u32 s41, 0
    s_cbranch_scc1 L_pl_1
    s_lshl_b32 s36, s36, 15
    buffer_load_dwordx4 v[64:67], v2, s[20:23], s36 offen nt
    buffer_load_dwordx4 v[68:71], v3, s[20:23], s36 offen nt
    buffer_load_dwordx4 v[72:75], v4, s[20:23], s36 offen nt
    buffer_load_dwordx4 v[76:79], v5, s[20:23], s36 offen nt
    s_branch L_it_0
L_pl_1:
    s_cmp_lg_u32 s41, 1
    s_cbranch_scc1 L_pl_2
    s_lshl_b32 s35, s35, 15
    buffer_load_dwordx4 v[96:99], v2, s[20:23], s35 offen nt
    buffer_load_dwordx4 v[100:103], v3, s[20:23], s35 offen nt
    buffer_load_dwordx4 v[104:107], v4, s[20:23], s35 offen nt
    buffer_load_dwordx4 v[108:111], v5, s[20:23], s35 offen nt
    s_branch L_it_1
L_pl_2:
    s_cmp_lg_u32 s41, 2
    s_cbranch_scc1 L_pl_3
    s_lshl_b32 s34, s34, 15
    buffer_load_dwordx4 v[64:67], v2, s[20:23], s34 offen nt
    buffer_load_dwordx4 v[68:71], v3, s[20:23], s34 offen nt
    buffer_load_dwordx4 v[72:75], v4, s[20:23], s34 offen nt
    buffer_load_dwordx4 v[76:79], v5, s[20:23], s34 offen nt
    s_branch L_it_2
L_pl_3:
    s_cmp_lg_u32 s41, 3
    s_cbranch_scc1 L_pl_4
    s_lshl_b32 s33, s33, 15
    buffer_load_dwordx4 v[96:99], v2, s[20:23], s33 offen nt
    buffer_load_dwordx4 v[100:103], v3, s[20:23], s33 offen nt
    buffer_load_dwordx4 v[104:107], v4, s[20:23], s33 offen nt
    buffer_load_dwordx4 v[108:111], v5, s[20:23], s33 offen nt
    s_branch L_it_3
L_pl_4:
    s_cmp_lg_u32 s41, 4
    s_cbranch_scc1 L_pl_5
    s_lshl_b32 s32, s32, 15
    buffer_load_dwordx4 v[64:67], v2, s[20:23], s32 offen nt
    buffer_load_dwordx4 v[68:71], v3, s[20:23], s32 offen nt
    buffer_load_dwordx4 v[72:75], v4, s[20:23], s32 offen nt
    buffer_load_dwordx4 v[76:79], v5, s[20:23], s32 offen nt
    s_branch L_it_4
L_pl_5:
    s_cmp_lg_u32 s41, 5
    s_cbranch_scc1 L_pl_6
    s_lshl_b32 s31, s31, 15
    buffer_load_dwordx4 v[96:99], v2, s[20:23], s31 offen nt
    buffer_load_dwordx4 v[100:103], v3, s[20:23], s31 offen nt
    buffer_load_dwordx4 v[104:107], v4, s[20:23], s31 offen nt
    buffer_load_dwordx4 v[108:111], v5, s[20:23], s31 offen nt
    s_branch L_it_5
L_pl_6:
    s_cmp_lg_u32 s41, 6
    s_cbranch_scc1 L_pl_7
    s_lshl_b32 s30, s30, 15
    buffer_load_dwordx4 v[64:67], v2, s[20:23], s30 offen nt
    buffer_load_dwordx4 v[68:71], v3, s[20:23], s30 offen nt
    buffer_load_dwordx4 v[72:75], v4, s[20:23], s30 offen nt
    buffer_load_dwordx4 v[76:79], v5, s[20:23], s30 offen nt
    s_branch L_it_6
L_pl_7:
    s_cmp_lg_u32 s41, 7
    s_cbranch_scc1 L_pl_8
    s_lshl_b32 s29, s29, 15
    buffer_load_dwordx4 v[96:99], v2, s[20:23], s29 offen nt
    buffer_load_dwordx4 v[100:103], v3, s[20:23], s29 offen nt
    buffer_load_dwordx4 v[104:107], v4, s[20:23], s29 offen nt
    buffer_load_dwordx4 v[108:111], v5, s[20:23], s29 offen nt
    s_branch L_it_7
L_pl_8:
    s_cmp_lg_u32 s41, 8
    s_cbranch_scc1 L_pl_9
    s_lshl_b32 s28, s28, 15
    buffer_load_dwordx4 v[64:67], v2, s[20:23], s28 offen nt
    buffer_load_dwordx4 v[68:71], v3, s[20:23], s28 offen nt
    buffer_load_dwordx4 v[72:75], v4, s[20:23], s28 offen nt
    buffer_load_dwordx4 v[76:79], v5, s[20:23], s28 offen nt
    s_branch L_it_8
L_pl_9:
    s_branch L_it_9
L_it_0:
    s_waitcnt vmcnt(3)
    buffer_load_dwordx4 v[80:83], v6, s[24:27], s36 offen nt
    v_mfma_f32_16x16x32_bf16 v[32:35], v[64:67], v[12:15], 0
    s_waitcnt vmcnt(3)
    buffer_load_dwordx4 v[84:87], v7, s[24:27], s36 offen nt
    v_mfma_f32_16x16x32_bf16 v[36:39], v[68:71], v[12:15], 0
    s_waitcnt vmcnt(3)
    buffer_load_dwordx4 v[88:91], v8, s[24:27], s36 offen nt
    v_mfma_f32_16x16x32_bf16 v[40:43], v[72:75], v[12:15], 0
    s_waitcnt vmcnt(3)
    buffer_load_dwordx4 v[92:95], v9, s[24:27], s36 offen nt
    v_mfma_f32_16x16x32_bf16 v[44:47], v[76:79], v[12:15], 0
    s_mul_i32 s43, s45, 128
    s_sub_i32 s43, s42, s43
    v_mul_f32_dpp v48, v32, v16 quad_perm:[0,0,0,0] row_mask:0xf bank_mask:0xf
    v_fmac_f32_dpp v48, v33, v16 quad_perm:[1,1,1,1] row_mask:0xf bank_mask:0xf
    v_fmac_f32_dpp v48, v34, v16 quad_perm:[2,2,2,2] row_mask:0xf bank_mask:0xf
    v_fmac_f32_dpp v48, v35, v16 quad_perm:[3,3,3,3] row_mask:0xf bank_mask:0xf
    v_mul_f32_dpp v49, v36, v16 quad_perm:[0,0,0,0] row_mask:0xf bank_mask:0xf
    v_fmac_f32_dpp v49, v37, v16 quad_perm:[1,1,1,1] row_mask:0xf bank_mask:0xf
    v_fmac_f32_dpp v49, v38, v16 quad_perm:[2,2,2,2] row_mask:0xf bank_mask:0xf
    v_fmac_f32_dpp v49, v39, v16 quad_perm:[3,3,3,3] row_mask:0xf bank_mask:0xf
    v_mul_f32_dpp v50, v40, v16 quad_perm:[0,0,0,0] row_mask:0xf bank_mask:0xf
    v_fmac_f32_dpp v50, v41, v16 quad_perm:[1,1,1,1] row_mask:0xf bank_mask:0xf
    v_fmac_f32_dpp v50, v42, v16 quad_perm:[2,2,2,2] row_mask:0xf bank_mask:0xf
    v_fmac_f32_dpp v50, v43, v16 quad_perm:[3,3,3,3] row_mask:0xf bank_mask:0xf
    v_mul_f32_dpp v51, v44, v16 quad_perm:[0,0,0,0] row_mask:0xf bank_mask:0xf
    v_fmac_f32_dpp v51, v45, v16 quad_perm:[1,1,1,1] row_mask:0xf bank_mask:0xf
    v_fmac_f32_dpp v51, v46, v16 quad_perm:[2,2,2,2] row_mask:0xf bank_mask:0xf
    v_fmac_f32_dpp v51, v47, v16 quad_perm:[3,3,3,3] row_mask:0xf bank_mask:0xf
    s_cmp_ge_i32 s43, 16
    s_cbranch_scc1 L_nomask_0
    s_sub_i32 s44, s43, 0
    v_cmp_gt_i32_e64 s[46:47], s44, v18
    s_sub_i32 s44, s43, 4
    v_cmp_gt_i32_e64 s[48:49], s44, v18
    s_sub_i32 s44, s43, 8
    v_cmp_gt_i32_e64 s[50:51], s44, v18
    s_sub_i32 s44, s43, 12
    v_cmp_gt_i32_e64 s[52:53], s44, v18
    v_cndmask_b32_e64 v48, v17, v48, s[46:47]
    v_cndmask_b32_e64 v49, v17, v49, s[48:49]
    v_cndmask_b32_e64 v50, v17, v50, s[50:51]
    v_cndmask_b32_e64 v51, v17, v51, s[52:53]
L_nomask_0:
    v_max3_f32 v22, v48, v49, v50
    v_max3_f32 v22, v22, v51, v20
    v_mov_b32 v23, v22
    s_nop 1
    v_permlane32_swap_b32 v22, v23
    v_max_f32 v22, v22, v23
    v_mov_b32 v23, v22
    s_nop 1
    v_permlane16_swap_b32 v22, v23
    v_max_f32 v22, v22, v23
    v_sub_f32 v19, v20, v22
    v_sub_f32 v48, v48, v22
    v_sub_f32 v49, v49, v22
    v_sub_f32 v50, v50, v22
    v_sub_f32 v51, v51, v22
    v_exp_f32 v19, v19
    v_exp_f32 v48, v48
    v_exp_f32 v49, v49
    v_exp_f32 v50, v50
    v_exp_f32 v51, v51
    v_mov_b32 v20, v22
    v_mul_f32 v24, v24, v19
    v_mul_f32 v25, v25, v19
    v_mul_f32 v26, v26, v19
    v_mul_f32 v27, v27, v19
    v_mul_f32 v28, v28, v19
    v_mul_f32 v29, v29, v19
    v_mul_f32 v30, v30, v19
    v_mul_f32 v31, v31, v19
    v_cvt_pk_bf16_f32 v32, v48, v48
    v_cvt_pk_bf16_f32 v33, v49, v49
    v_cvt_pk_bf16_f32 v34, v50, v50
    v_cvt_pk_bf16_f32 v35, v51, v51
    v_fma_f32 v21, v21, v19, v48
    v_add_f32 v22, v49, v50
    v_and_b32 v52, v32, v10
    v_and_b32 v53, v32, v11
    v_and_b32 v54, v33, v10
    v_and_b32 v55, v33, v11
    v_and_b32 v56, v34, v10
    v_and_b32 v57, v34, v11
    v_and_b32 v58, v35, v10
    v_and_b32 v59, v35, v11
    v_add_f32 v21, v21, v51
    v_add_f32 v21, v21, v22
    s_waitcnt vmcnt(3)
    s_lshl_b32 s35, s35, 15
    buffer_load_dwordx4 v[96:99], v2, s[20:23], s35 offen nt
    v_mfma_f32_16x16x16_bf16 v[24:27], v[80:81], v[52:53], v[24:27]
    v_mfma_f32_16x16x16_bf16 v[28:31], v[82:83], v[52:53], v[28:31]
    s_waitcnt vmcnt(3)
    buffer_load_dwordx4 v[100:103], v3, s[20:23], s35 offen nt
    v_mfma_f32_16x16x16_bf16 v[24:27], v[84:85], v[54:55], v[24:27]
    v_mfma_f32_16x16x16_bf16 v[28:31], v[86:87], v[54:55], v[28:31]
    s_waitcnt vmcnt(3)
    buffer_load_dwordx4 v[104:107], v4, s[20:23], s35 offen nt
    v_mfma_f32_16x16x16_bf16 v[24:27], v[88:89], v[56:57], v[24:27]
    v_mfma_f32_16x16x16_bf16 v[28:31], v[90:91], v[56:57], v[28:31]
    s_waitcnt vmcnt(3)
    buffer_load_dwordx4 v[108:111], v5, s[20:23], s35 offen nt
    v_mfma_f32_16x16x16_bf16 v[24:27], v[92:93], v[58:59], v[24:27]
    v_mfma_f32_16x16x16_bf16 v[28:31], v[94:95], v[58:59], v[28:31]
L_it_1:
    s_waitcnt vmcnt(3)
    buffer_load_dwordx4 v[112:115], v6, s[24:27], s35 offen nt
    v_mfma_f32_16x16x32_bf16 v[32:35], v[96:99], v[12:15], 0
    s_waitcnt vmcnt(3)
    buffer_load_dwordx4 v[116:119], v7, s[24:27], s35 offen nt
    v_mfma_f32_16x16x32_bf16 v[36:39], v[100:103], v[12:15], 0
    s_waitcnt vmcnt(3)
    buffer_load_dwordx4 v[120:123], v8, s[24:27], s35 offen nt
    v_mfma_f32_16x16x32_bf16 v[40:43], v[104:107], v[12:15], 0
    s_waitcnt vmcnt(3)
    buffer_load_dwordx4 v[124:127], v9, s[24:27], s35 offen nt
    v_mfma_f32_16x16x32_bf16 v[44:47], v[108:111], v[12:15], 0
    s_mul_i32 s43, s45, 112
    s_sub_i32 s43, s42, s43
    v_mul_f32_dpp v48, v32, v16 quad_perm:[0,0,0,0] row_mask:0xf bank_mask:0xf
    v_fmac_f32_dpp v48, v33, v16 quad_perm:[1,1,1,1] row_mask:0xf bank_mask:0xf
    v_fmac_f32_dpp v48, v34, v16 quad_perm:[2,2,2,2] row_mask:0xf bank_mask:0xf
    v_fmac_f32_dpp v48, v35, v16 quad_perm:[3,3,3,3] row_mask:0xf bank_mask:0xf
    v_mul_f32_dpp v49, v36, v16 quad_perm:[0,0,0,0] row_mask:0xf bank_mask:0xf
    v_fmac_f32_dpp v49, v37, v16 quad_perm:[1,1,1,1] row_mask:0xf bank_mask:0xf
    v_fmac_f32_dpp v49, v38, v16 quad_perm:[2,2,2,2] row_mask:0xf bank_mask:0xf
    v_fmac_f32_dpp v49, v39, v16 quad_perm:[3,3,3,3] row_mask:0xf bank_mask:0xf
    v_mul_f32_dpp v50, v40, v16 quad_perm:[0,0,0,0] row_mask:0xf bank_mask:0xf
    v_fmac_f32_dpp v50, v41, v16 quad_perm:[1,1,1,1] row_mask:0xf bank_mask:0xf
    v_fmac_f32_dpp v50, v42, v16 quad_perm:[2,2,2,2] row_mask:0xf bank_mask:0xf
    v_fmac_f32_dpp v50, v43, v16 quad_perm:[3,3,3,3] row_mask:0xf bank_mask:0xf
    v_mul_f32_dpp v51, v44, v16 quad_perm:[0,0,0,0] row_mask:0xf bank_mask:0xf
    v_fmac_f32_dpp v51, v45, v16 quad_perm:[1,1,1,1] row_mask:0xf bank_mask:0xf
    v_fmac_f32_dpp v51, v46, v16 quad_perm:[2,2,2,2] row_mask:0xf bank_mask:0xf
    v_fmac_f32_dpp v51, v47, v16 quad_perm:[3,3,3,3] row_mask:0xf bank_mask:0xf
    s_cmp_ge_i32 s43, 16
    s_cbranch_scc1 L_nomask_1
    s_sub_i32 s44, s43, 0
    v_cmp_gt_i32_e64 s[46:47], s44, v18
    s_sub_i32 s44, s43, 4
    v_cmp_gt_i32_e64 s[48:49], s44, v18
    s_sub_i32 s44, s43, 8
    v_cmp_gt_i32_e64 s[50:51], s44, v18
    s_sub_i32 s44, s43, 12
    v_cmp_gt_i32_e64 s[52:53], s44, v18
    v_cndmask_b32_e64 v48, v17, v48, s[46:47]
    v_cndmask_b32_e64 v49, v17, v49, s[48:49]
    v_cndmask_b32_e64 v50, v17, v50, s[50:51]
    v_cndmask_b32_e64 v51, v17, v51, s[52:53]
L_nomask_1:
    v_max3_f32 v22, v48, v49, v50
    v_max3_f32 v22, v22, v51, v20
    v_mov_b32 v23, v22
    s_nop 1
    v_permlane32_swap_b32 v22, v23
    v_max_f32 v22, v22, v23
    v_mov_b32 v23, v22
    s_nop 1
    v_permlane16_swap_b32 v22, v23
    v_max_f32 v22, v22, v23
    v_sub_f32 v19, v20, v22
    v_sub_f32 v48, v48, v22
    v_sub_f32 v49, v49, v22
    v_sub_f32 v50, v50, v22
    v_sub_f32 v51, v51, v22
    v_exp_f32 v19, v19
    v_exp_f32 v48, v48
    v_exp_f32 v49, v49
    v_exp_f32 v50, v50
    v_exp_f32 v51, v51
    v_mov_b32 v20, v22
    v_mul_f32 v24, v24, v19
    v_mul_f32 v25, v25, v19
    v_mul_f32 v26, v26, v19
    v_mul_f32 v27, v27, v19
    v_mul_f32 v28, v28, v19
    v_mul_f32 v29, v29, v19
    v_mul_f32 v30, v30, v19
    v_mul_f32 v31, v31, v19
    v_cvt_pk_bf16_f32 v32, v48, v48
    v_cvt_pk_bf16_f32 v33, v49, v49
    v_cvt_pk_bf16_f32 v34, v50, v50
    v_cvt_pk_bf16_f32 v35, v51, v51
    v_fma_f32 v21, v21, v19, v48
    v_add_f32 v22, v49, v50
    v_and_b32 v52, v32, v10
    v_and_b32 v53, v32, v11
    v_and_b32 v54, v33, v10
    v_and_b32 v55, v33, v11
    v_and_b32 v56, v34, v10
    v_and_b32 v57, v34, v11
    v_and_b32 v58, v35, v10
    v_and_b32 v59, v35, v11
    v_add_f32 v21, v21, v51
    v_add_f32 v21, v21, v22
    s_waitcnt vmcnt(3)
    s_lshl_b32 s34, s34, 15
    buffer_load_dwordx4 v[64:67], v2, s[20:23], s34 offen nt
    v_mfma_f32_16x16x16_bf16 v[24:27], v[112:113], v[52:53], v[24:27]
    v_mfma_f32_16x16x16_bf16 v[28:31], v[114:115], v[52:53], v[28:31]
    s_waitcnt vmcnt(3)
    buffer_load_dwordx4 v[68:71], v3, s[20:23], s34 offen nt
    v_mfma_f32_16x16x16_bf16 v[24:27], v[116:117], v[54:55], v[24:27]
    v_mfma_f32_16x16x16_bf16 v[28:31], v[118:119], v[54:55], v[28:31]
    s_waitcnt vmcnt(3)
    buffer_load_dwordx4 v[72:75], v4, s[20:23], s34 offen nt
    v_mfma_f32_16x16x16_bf16 v[24:27], v[120:121], v[56:57], v[24:27]
    v_mfma_f32_16x16x16_bf16 v[28:31], v[122:123], v[56:57], v[28:31]
    s_waitcnt vmcnt(3)
    buffer_load_dwordx4 v[76:79], v5, s[20:23], s34 offen nt
    v_mfma_f32_16x16x16_bf16 v[24:27], v[124:125], v[58:59], v[24:27]
    v_mfma_f32_16x16x16_bf16 v[28:31], v[126:127], v[58:59], v[28:31]
L_it_2:
    s_waitcnt vmcnt(3)
    buffer_load_dwordx4 v[80:83], v6, s[24:27], s34 offen nt
    v_mfma_f32_16x16x32_bf16 v[32:35], v[64:67], v[12:15], 0
    s_waitcnt vmcnt(3)
    buffer_load_dwordx4 v[84:87], v7, s[24:27], s34 offen nt
    v_mfma_f32_16x16x32_bf16 v[36:39], v[68:71], v[12:15], 0
    s_waitcnt vmcnt(3)
    buffer_load_dwordx4 v[88:91], v8, s[24:27], s34 offen nt
    v_mfma_f32_16x16x32_bf16 v[40:43], v[72:75], v[12:15], 0
    s_waitcnt vmcnt(3)
    buffer_load_dwordx4 v[92:95], v9, s[24:27], s34 offen nt
    v_mfma_f32_16x16x32_bf16 v[44:47], v[76:79], v[12:15], 0
    s_mul_i32 s43, s45, 96
    s_sub_i32 s43, s42, s43
    v_mul_f32_dpp v48, v32, v16 quad_perm:[0,0,0,0] row_mask:0xf bank_mask:0xf
    v_fmac_f32_dpp v48, v33, v16 quad_perm:[1,1,1,1] row_mask:0xf bank_mask:0xf
    v_fmac_f32_dpp v48, v34, v16 quad_perm:[2,2,2,2] row_mask:0xf bank_mask:0xf
    v_fmac_f32_dpp v48, v35, v16 quad_perm:[3,3,3,3] row_mask:0xf bank_mask:0xf
    v_mul_f32_dpp v49, v36, v16 quad_perm:[0,0,0,0] row_mask:0xf bank_mask:0xf
    v_fmac_f32_dpp v49, v37, v16 quad_perm:[1,1,1,1] row_mask:0xf bank_mask:0xf
    v_fmac_f32_dpp v49, v38, v16 quad_perm:[2,2,2,2] row_mask:0xf bank_mask:0xf
    v_fmac_f32_dpp v49, v39, v16 quad_perm:[3,3,3,3] row_mask:0xf bank_mask:0xf
    v_mul_f32_dpp v50, v40, v16 quad_perm:[0,0,0,0] row_mask:0xf bank_mask:0xf
    v_fmac_f32_dpp v50, v41, v16 quad_perm:[1,1,1,1] row_mask:0xf bank_mask:0xf
    v_fmac_f32_dpp v50, v42, v16 quad_perm:[2,2,2,2] row_mask:0xf bank_mask:0xf
    v_fmac_f32_dpp v50, v43, v16 quad_perm:[3,3,3,3] row_mask:0xf bank_mask:0xf
    v_mul_f32_dpp v51, v44, v16 quad_perm:[0,0,0,0] row_mask:0xf bank_mask:0xf
    v_fmac_f32_dpp v51, v45, v16 quad_perm:[1,1,1,1] row_mask:0xf bank_mask:0xf
    v_fmac_f32_dpp v51, v46, v16 quad_perm:[2,2,2,2] row_mask:0xf bank_mask:0xf
    v_fmac_f32_dpp v51, v47, v16 quad_perm:[3,3,3,3] row_mask:0xf bank_mask:0xf
    s_cmp_ge_i32 s43, 16
    s_cbranch_scc1 L_nomask_2
    s_sub_i32 s44, s43, 0
    v_cmp_gt_i32_e64 s[46:47], s44, v18
    s_sub_i32 s44, s43, 4
    v_cmp_gt_i32_e64 s[48:49], s44, v18
    s_sub_i32 s44, s43, 8
    v_cmp_gt_i32_e64 s[50:51], s44, v18
    s_sub_i32 s44, s43, 12
    v_cmp_gt_i32_e64 s[52:53], s44, v18
    v_cndmask_b32_e64 v48, v17, v48, s[46:47]
    v_cndmask_b32_e64 v49, v17, v49, s[48:49]
    v_cndmask_b32_e64 v50, v17, v50, s[50:51]
    v_cndmask_b32_e64 v51, v17, v51, s[52:53]
L_nomask_2:
    v_max3_f32 v22, v48, v49, v50
    v_max3_f32 v22, v22, v51, v20
    v_mov_b32 v23, v22
    s_nop 1
    v_permlane32_swap_b32 v22, v23
    v_max_f32 v22, v22, v23
    v_mov_b32 v23, v22
    s_nop 1
    v_permlane16_swap_b32 v22, v23
    v_max_f32 v22, v22, v23
    v_sub_f32 v19, v20, v22
    v_sub_f32 v48, v48, v22
    v_sub_f32 v49, v49, v22
    v_sub_f32 v50, v50, v22
    v_sub_f32 v51, v51, v22
    v_exp_f32 v19, v19
    v_exp_f32 v48, v48
    v_exp_f32 v49, v49
    v_exp_f32 v50, v50
    v_exp_f32 v51, v51
    v_mov_b32 v20, v22
    v_mul_f32 v24, v24, v19
    v_mul_f32 v25, v25, v19
    v_mul_f32 v26, v26, v19
    v_mul_f32 v27, v27, v19
    v_mul_f32 v28, v28, v19
    v_mul_f32 v29, v29, v19
    v_mul_f32 v30, v30, v19
    v_mul_f32 v31, v31, v19
    v_cvt_pk_bf16_f32 v32, v48, v48
    v_cvt_pk_bf16_f32 v33, v49, v49
    v_cvt_pk_bf16_f32 v34, v50, v50
    v_cvt_pk_bf16_f32 v35, v51, v51
    v_fma_f32 v21, v21, v19, v48
    v_add_f32 v22, v49, v50
    v_and_b32 v52, v32, v10
    v_and_b32 v53, v32, v11
    v_and_b32 v54, v33, v10
    v_and_b32 v55, v33, v11
    v_and_b32 v56, v34, v10
    v_and_b32 v57, v34, v11
    v_and_b32 v58, v35, v10
    v_and_b32 v59, v35, v11
    v_add_f32 v21, v21, v51
    v_add_f32 v21, v21, v22
    s_waitcnt vmcnt(3)
    s_lshl_b32 s33, s33, 15
    buffer_load_dwordx4 v[96:99], v2, s[20:23], s33 offen nt
    v_mfma_f32_16x16x16_bf16 v[24:27], v[80:81], v[52:53], v[24:27]
    v_mfma_f32_16x16x16_bf16 v[28:31], v[82:83], v[52:53], v[28:31]
    s_waitcnt vmcnt(3)
    buffer_load_dwordx4 v[100:103], v3, s[20:23], s33 offen nt
    v_mfma_f32_16x16x16_bf16 v[24:27], v[84:85], v[54:55], v[24:27]
    v_mfma_f32_16x16x16_bf16 v[28:31], v[86:87], v[54:55], v[28:31]
    s_waitcnt vmcnt(3)
    buffer_load_dwordx4 v[104:107], v4, s[20:23], s33 offen nt
    v_mfma_f32_16x16x16_bf16 v[24:27], v[88:89], v[56:57], v[24:27]
    v_mfma_f32_16x16x16_bf16 v[28:31], v[90:91], v[56:57], v[28:31]
    s_waitcnt vmcnt(3)
    buffer_load_dwordx4 v[108:111], v5, s[20:23], s33 offen nt
    v_mfma_f32_16x16x16_bf16 v[24:27], v[92:93], v[58:59], v[24:27]
    v_mfma_f32_16x16x16_bf16 v[28:31], v[94:95], v[58:59], v[28:31]
L_it_3:
    s_waitcnt vmcnt(3)
    buffer_load_dwordx4 v[112:115], v6, s[24:27], s33 offen nt
    v_mfma_f32_16x16x32_bf16 v[32:35], v[96:99], v[12:15], 0
    s_waitcnt vmcnt(3)
    buffer_load_dwordx4 v[116:119], v7, s[24:27], s33 offen nt
    v_mfma_f32_16x16x32_bf16 v[36:39], v[100:103], v[12:15], 0
    s_waitcnt vmcnt(3)
    buffer_load_dwordx4 v[120:123], v8, s[24:27], s33 offen nt
    v_mfma_f32_16x16x32_bf16 v[40:43], v[104:107], v[12:15], 0
    s_waitcnt vmcnt(3)
    buffer_load_dwordx4 v[124:127], v9, s[24:27], s33 offen nt
    v_mfma_f32_16x16x32_bf16 v[44:47], v[108:111], v[12:15], 0
    s_mul_i32 s43, s45, 80
    s_sub_i32 s43, s42, s43
    v_mul_f32_dpp v48, v32, v16 quad_perm:[0,0,0,0] row_mask:0xf bank_mask:0xf
    v_fmac_f32_dpp v48, v33, v16 quad_perm:[1,1,1,1] row_mask:0xf bank_mask:0xf
    v_fmac_f32_dpp v48, v34, v16 quad_perm:[2,2,2,2] row_mask:0xf bank_mask:0xf
    v_fmac_f32_dpp v48, v35, v16 quad_perm:[3,3,3,3] row_mask:0xf bank_mask:0xf
    v_mul_f32_dpp v49, v36, v16 quad_perm:[0,0,0,0] row_mask:0xf bank_mask:0xf
    v_fmac_f32_dpp v49, v37, v16 quad_perm:[1,1,1,1] row_mask:0xf bank_mask:0xf
    v_fmac_f32_dpp v49, v38, v16 quad_perm:[2,2,2,2] row_mask:0xf bank_mask:0xf
    v_fmac_f32_dpp v49, v39, v16 quad_perm:[3,3,3,3] row_mask:0xf bank_mask:0xf
    v_mul_f32_dpp v50, v40, v16 quad_perm:[0,0,0,0] row_mask:0xf bank_mask:0xf
    v_fmac_f32_dpp v50, v41, v16 quad_perm:[1,1,1,1] row_mask:0xf bank_mask:0xf
    v_fmac_f32_dpp v50, v42, v16 quad_perm:[2,2,2,2] row_mask:0xf bank_mask:0xf
    v_fmac_f32_dpp v50, v43, v16 quad_perm:[3,3,3,3] row_mask:0xf bank_mask:0xf
    v_mul_f32_dpp v51, v44, v16 quad_perm:[0,0,0,0] row_mask:0xf bank_mask:0xf
    v_fmac_f32_dpp v51, v45, v16 quad_perm:[1,1,1,1] row_mask:0xf bank_mask:0xf
    v_fmac_f32_dpp v51, v46, v16 quad_perm:[2,2,2,2] row_mask:0xf bank_mask:0xf
    v_fmac_f32_dpp v51, v47, v16 quad_perm:[3,3,3,3] row_mask:0xf bank_mask:0xf
    s_cmp_ge_i32 s43, 16
    s_cbranch_scc1 L_nomask_3
    s_sub_i32 s44, s43, 0
    v_cmp_gt_i32_e64 s[46:47], s44, v18
    s_sub_i32 s44, s43, 4
    v_cmp_gt_i32_e64 s[48:49], s44, v18
    s_sub_i32 s44, s43, 8
    v_cmp_gt_i32_e64 s[50:51], s44, v18
    s_sub_i32 s44, s43, 12
    v_cmp_gt_i32_e64 s[52:53], s44, v18
    v_cndmask_b32_e64 v48, v17, v48, s[46:47]
    v_cndmask_b32_e64 v49, v17, v49, s[48:49]
    v_cndmask_b32_e64 v50, v17, v50, s[50:51]
    v_cndmask_b32_e64 v51, v17, v51, s[52:53]
L_nomask_3:
    v_max3_f32 v22, v48, v49, v50
    v_max3_f32 v22, v22, v51, v20
    v_mov_b32 v23, v22
    s_nop 1
    v_permlane32_swap_b32 v22, v23
    v_max_f32 v22, v22, v23
    v_mov_b32 v23, v22
    s_nop 1
    v_permlane16_swap_b32 v22, v23
    v_max_f32 v22, v22, v23
    v_sub_f32 v19, v20, v22
    v_sub_f32 v48, v48, v22
    v_sub_f32 v49, v49, v22
    v_sub_f32 v50, v50, v22
    v_sub_f32 v51, v51, v22
    v_exp_f32 v19, v19
    v_exp_f32 v48, v48
    v_exp_f32 v49, v49
    v_exp_f32 v50, v50
    v_exp_f32 v51, v51
    v_mov_b32 v20, v22
    v_mul_f32 v24, v24, v19
    v_mul_f32 v25, v25, v19
    v_mul_f32 v26, v26, v19
    v_mul_f32 v27, v27, v19
    v_mul_f32 v28, v28, v19
    v_mul_f32 v29, v29, v19
    v_mul_f32 v30, v30, v19
    v_mul_f32 v31, v31, v19
    v_cvt_pk_bf16_f32 v32, v48, v48
    v_cvt_pk_bf16_f32 v33, v49, v49
    v_cvt_pk_bf16_f32 v34, v50, v50
    v_cvt_pk_bf16_f32 v35, v51, v51
    v_fma_f32 v21, v21, v19, v48
    v_add_f32 v22, v49, v50
    v_and_b32 v52, v32, v10
    v_and_b32 v53, v32, v11
    v_and_b32 v54, v33, v10
    v_and_b32 v55, v33, v11
    v_and_b32 v56, v34, v10
    v_and_b32 v57, v34, v11
    v_and_b32 v58, v35, v10
    v_and_b32 v59, v35, v11
    v_add_f32 v21, v21, v51
    v_add_f32 v21, v21, v22
    s_waitcnt vmcnt(3)
    s_lshl_b32 s32, s32, 15
    buffer_load_dwordx4 v[64:67], v2, s[20:23], s32 offen nt
    v_mfma_f32_16x16x16_bf16 v[24:27], v[112:113], v[52:53], v[24:27]
    v_mfma_f32_16x16x16_bf16 v[28:31], v[114:115], v[52:53], v[28:31]
    s_waitcnt vmcnt(3)
    buffer_load_dwordx4 v[68:71], v3, s[20:23], s32 offen nt
    v_mfma_f32_16x16x16_bf16 v[24:27], v[116:117], v[54:55], v[24:27]
    v_mfma_f32_16x16x16_bf16 v[28:31], v[118:119], v[54:55], v[28:31]
    s_waitcnt vmcnt(3)
    buffer_load_dwordx4 v[72:75], v4, s[20:23], s32 offen nt
    v_mfma_f32_16x16x16_bf16 v[24:27], v[120:121], v[56:57], v[24:27]
    v_mfma_f32_16x16x16_bf16 v[28:31], v[122:123], v[56:57], v[28:31]
    s_waitcnt vmcnt(3)
    buffer_load_dwordx4 v[76:79], v5, s[20:23], s32 offen nt
    v_mfma_f32_16x16x16_bf16 v[24:27], v[124:125], v[58:59], v[24:27]
    v_mfma_f32_16x16x16_bf16 v[28:31], v[126:127], v[58:59], v[28:31]
L_it_4:
    s_waitcnt vmcnt(3)
    buffer_load_dwordx4 v[80:83], v6, s[24:27], s32 offen nt
    v_mfma_f32_16x16x32_bf16 v[32:35], v[64:67], v[12:15], 0
    s_waitcnt vmcnt(3)
    buffer_load_dwordx4 v[84:87], v7, s[24:27], s32 offen nt
    v_mfma_f32_16x16x32_bf16 v[36:39], v[68:71], v[12:15], 0
    s_waitcnt vmcnt(3)
    buffer_load_dwordx4 v[88:91], v8, s[24:27], s32 offen nt
    v_mfma_f32_16x16x32_bf16 v[40:43], v[72:75], v[12:15], 0
    s_waitcnt vmcnt(3)
    buffer_load_dwordx4 v[92:95], v9, s[24:27], s32 offen nt
    v_mfma_f32_16x16x32_bf16 v[44:47], v[76:79], v[12:15], 0
    s_mul_i32 s43, s45, 64
    s_sub_i32 s43, s42, s43
    v_mul_f32_dpp v48, v32, v16 quad_perm:[0,0,0,0] row_mask:0xf bank_mask:0xf
    v_fmac_f32_dpp v48, v33, v16 quad_perm:[1,1,1,1] row_mask:0xf bank_mask:0xf
    v_fmac_f32_dpp v48, v34, v16 quad_perm:[2,2,2,2] row_mask:0xf bank_mask:0xf
    v_fmac_f32_dpp v48, v35, v16 quad_perm:[3,3,3,3] row_mask:0xf bank_mask:0xf
    v_mul_f32_dpp v49, v36, v16 quad_perm:[0,0,0,0] row_mask:0xf bank_mask:0xf
    v_fmac_f32_dpp v49, v37, v16 quad_perm:[1,1,1,1] row_mask:0xf bank_mask:0xf
    v_fmac_f32_dpp v49, v38, v16 quad_perm:[2,2,2,2] row_mask:0xf bank_mask:0xf
    v_fmac_f32_dpp v49, v39, v16 quad_perm:[3,3,3,3] row_mask:0xf bank_mask:0xf
    v_mul_f32_dpp v50, v40, v16 quad_perm:[0,0,0,0] row_mask:0xf bank_mask:0xf
    v_fmac_f32_dpp v50, v41, v16 quad_perm:[1,1,1,1] row_mask:0xf bank_mask:0xf
    v_fmac_f32_dpp v50, v42, v16 quad_perm:[2,2,2,2] row_mask:0xf bank_mask:0xf
    v_fmac_f32_dpp v50, v43, v16 quad_perm:[3,3,3,3] row_mask:0xf bank_mask:0xf
    v_mul_f32_dpp v51, v44, v16 quad_perm:[0,0,0,0] row_mask:0xf bank_mask:0xf
    v_fmac_f32_dpp v51, v45, v16 quad_perm:[1,1,1,1] row_mask:0xf bank_mask:0xf
    v_fmac_f32_dpp v51, v46, v16 quad_perm:[2,2,2,2] row_mask:0xf bank_mask:0xf
    v_fmac_f32_dpp v51, v47, v16 quad_perm:[3,3,3,3] row_mask:0xf bank_mask:0xf
    s_cmp_ge_i32 s43, 16
    s_cbranch_scc1 L_nomask_4
    s_sub_i32 s44, s43, 0
    v_cmp_gt_i32_e64 s[46:47], s44, v18
    s_sub_i32 s44, s43, 4
    v_cmp_gt_i32_e64 s[48:49], s44, v18
    s_sub_i32 s44, s43, 8
    v_cmp_gt_i32_e64 s[50:51], s44, v18
    s_sub_i32 s44, s43, 12
    v_cmp_gt_i32_e64 s[52:53], s44, v18
    v_cndmask_b32_e64 v48, v17, v48, s[46:47]
    v_cndmask_b32_e64 v49, v17, v49, s[48:49]
    v_cndmask_b32_e64 v50, v17, v50, s[50:51]
    v_cndmask_b32_e64 v51, v17, v51, s[52:53]
L_nomask_4:
    v_max3_f32 v22, v48, v49, v50
    v_max3_f32 v22, v22, v51, v20
    v_mov_b32 v23, v22
    s_nop 1
    v_permlane32_swap_b32 v22, v23
    v_max_f32 v22, v22, v23
    v_mov_b32 v23, v22
    s_nop 1
    v_permlane16_swap_b32 v22, v23
    v_max_f32 v22, v22, v23
    v_sub_f32 v19, v20, v22
    v_sub_f32 v48, v48, v22
    v_sub_f32 v49, v49, v22
    v_sub_f32 v50, v50, v22
    v_sub_f32 v51, v51, v22
    v_exp_f32 v19, v19
    v_exp_f32 v48, v48
    v_exp_f32 v49, v49
    v_exp_f32 v50, v50
    v_exp_f32 v51, v51
    v_mov_b32 v20, v22
    v_mul_f32 v24, v24, v19
    v_mul_f32 v25, v25, v19
    v_mul_f32 v26, v26, v19
    v_mul_f32 v27, v27, v19
    v_mul_f32 v28, v28, v19
    v_mul_f32 v29, v29, v19
    v_mul_f32 v30, v30, v19
    v_mul_f32 v31, v31, v19
    v_cvt_pk_bf16_f32 v32, v48, v48
    v_cvt_pk_bf16_f32 v33, v49, v49
    v_cvt_pk_bf16_f32 v34, v50, v50
    v_cvt_pk_bf16_f32 v35, v51, v51
    v_fma_f32 v21, v21, v19, v48
    v_add_f32 v22, v49, v50
    v_and_b32 v52, v32, v10
    v_and_b32 v53, v32, v11
    v_and_b32 v54, v33, v10
    v_and_b32 v55, v33, v11
    v_and_b32 v56, v34, v10
    v_and_b32 v57, v34, v11
    v_and_b32 v58, v35, v10
    v_and_b32 v59, v35, v11
    v_add_f32 v21, v21, v51
    v_add_f32 v21, v21, v22
    s_waitcnt vmcnt(3)
    s_lshl_b32 s31, s31, 15
    buffer_load_dwordx4 v[96:99], v2, s[20:23], s31 offen nt
    v_mfma_f32_16x16x16_bf16 v[24:27], v[80:81], v[52:53], v[24:27]
    v_mfma_f32_16x16x16_bf16 v[28:31], v[82:83], v[52:53], v[28:31]
    s_waitcnt vmcnt(3)
    buffer_load_dwordx4 v[100:103], v3, s[20:23], s31 offen nt
    v_mfma_f32_16x16x16_bf16 v[24:27], v[84:85], v[54:55], v[24:27]
    v_mfma_f32_16x16x16_bf16 v[28:31], v[86:87], v[54:55], v[28:31]
    s_waitcnt vmcnt(3)
    buffer_load_dwordx4 v[104:107], v4, s[20:23], s31 offen nt
    v_mfma_f32_16x16x16_bf16 v[24:27], v[88:89], v[56:57], v[24:27]
    v_mfma_f32_16x16x16_bf16 v[28:31], v[90:91], v[56:57], v[28:31]
    s_waitcnt vmcnt(3)
    buffer_load_dwordx4 v[108:111], v5, s[20:23], s31 offen nt
    v_mfma_f32_16x16x16_bf16 v[24:27], v[92:93], v[58:59], v[24:27]
    v_mfma_f32_16x16x16_bf16 v[28:31], v[94:95], v[58:59], v[28:31]
L_it_5:
    s_waitcnt vmcnt(3)
    buffer_load_dwordx4 v[112:115], v6, s[24:27], s31 offen nt
    v_mfma_f32_16x16x32_bf16 v[32:35], v[96:99], v[12:15], 0
    s_waitcnt vmcnt(3)
    buffer_load_dwordx4 v[116:119], v7, s[24:27], s31 offen nt
    v_mfma_f32_16x16x32_bf16 v[36:39], v[100:103], v[12:15], 0
    s_waitcnt vmcnt(3)
    buffer_load_dwordx4 v[120:123], v8, s[24:27], s31 offen nt
    v_mfma_f32_16x16x32_bf16 v[40:43], v[104:107], v[12:15], 0
    s_waitcnt vmcnt(3)
    buffer_load_dwordx4 v[124:127], v9, s[24:27], s31 offen nt
    v_mfma_f32_16x16x32_bf16 v[44:47], v[108:111], v[12:15], 0
    s_mul_i32 s43, s45, 48
    s_sub_i32 s43, s42, s43
    v_mul_f32_dpp v48, v32, v16 quad_perm:[0,0,0,0] row_mask:0xf bank_mask:0xf
    v_fmac_f32_dpp v48, v33, v16 quad_perm:[1,1,1,1] row_mask:0xf bank_mask:0xf
    v_fmac_f32_dpp v48, v34, v16 quad_perm:[2,2,2,2] row_mask:0xf bank_mask:0xf
    v_fmac_f32_dpp v48, v35, v16 quad_perm:[3,3,3,3] row_mask:0xf bank_mask:0xf
    v_mul_f32_dpp v49, v36, v16 quad_perm:[0,0,0,0] row_mask:0xf bank_mask:0xf
    v_fmac_f32_dpp v49, v37, v16 quad_perm:[1,1,1,1] row_mask:0xf bank_mask:0xf
    v_fmac_f32_dpp v49, v38, v16 quad_perm:[2,2,2,2] row_mask:0xf bank_mask:0xf
    v_fmac_f32_dpp v49, v39, v16 quad_perm:[3,3,3,3] row_mask:0xf bank_mask:0xf
    v_mul_f32_dpp v50, v40, v16 quad_perm:[0,0,0,0] row_mask:0xf bank_mask:0xf
    v_fmac_f32_dpp v50, v41, v16 quad_perm:[1,1,1,1] row_mask:0xf bank_mask:0xf
    v_fmac_f32_dpp v50, v42, v16 quad_perm:[2,2,2,2] row_mask:0xf bank_mask:0xf
    v_fmac_f32_dpp v50, v43, v16 quad_perm:[3,3,3,3] row_mask:0xf bank_mask:0xf
    v_mul_f32_dpp v51, v44, v16 quad_perm:[0,0,0,0] row_mask:0xf bank_mask:0xf
    v_fmac_f32_dpp v51, v45, v16 quad_perm:[1,1,1,1] row_mask:0xf bank_mask:0xf
    v_fmac_f32_dpp v51, v46, v16 quad_perm:[2,2,2,2] row_mask:0xf bank_mask:0xf
    v_fmac_f32_dpp v51, v47, v16 quad_perm:[3,3,3,3] row_mask:0xf bank_mask:0xf
    s_cmp_ge_i32 s43, 16
    s_cbranch_scc1 L_nomask_5
    s_sub_i32 s44, s43, 0
    v_cmp_gt_i32_e64 s[46:47], s44, v18
    s_sub_i32 s44, s43, 4
    v_cmp_gt_i32_e64 s[48:49], s44, v18
    s_sub_i32 s44, s43, 8
    v_cmp_gt_i32_e64 s[50:51], s44, v18
    s_sub_i32 s44, s43, 12
    v_cmp_gt_i32_e64 s[52:53], s44, v18
    v_cndmask_b32_e64 v48, v17, v48, s[46:47]
    v_cndmask_b32_e64 v49, v17, v49, s[48:49]
    v_cndmask_b32_e64 v50, v17, v50, s[50:51]
    v_cndmask_b32_e64 v51, v17, v51, s[52:53]
L_nomask_5:
    v_max3_f32 v22, v48, v49, v50
    v_max3_f32 v22, v22, v51, v20
    v_mov_b32 v23, v22
    s_nop 1
    v_permlane32_swap_b32 v22, v23
    v_max_f32 v22, v22, v23
    v_mov_b32 v23, v22
    s_nop 1
    v_permlane16_swap_b32 v22, v23
    v_max_f32 v22, v22, v23
    v_sub_f32 v19, v20, v22
    v_sub_f32 v48, v48, v22
    v_sub_f32 v49, v49, v22
    v_sub_f32 v50, v50, v22
    v_sub_f32 v51, v51, v22
    v_exp_f32 v19, v19
    v_exp_f32 v48, v48
    v_exp_f32 v49, v49
    v_exp_f32 v50, v50
    v_exp_f32 v51, v51
    v_mov_b32 v20, v22
    v_mul_f32 v24, v24, v19
    v_mul_f32 v25, v25, v19
    v_mul_f32 v26, v26, v19
    v_mul_f32 v27, v27, v19
    v_mul_f32 v28, v28, v19
    v_mul_f32 v29, v29, v19
    v_mul_f32 v30, v30, v19
    v_mul_f32 v31, v31, v19
    v_cvt_pk_bf16_f32 v32, v48, v48
    v_cvt_pk_bf16_f32 v33, v49, v49
    v_cvt_pk_bf16_f32 v34, v50, v50
    v_cvt_pk_bf16_f32 v35, v51, v51
    v_fma_f32 v21, v21, v19, v48
    v_add_f32 v22, v49, v50
    v_and_b32 v52, v32, v10
    v_and_b32 v53, v32, v11
    v_and_b32 v54, v33, v10
    v_and_b32 v55, v33, v11
    v_and_b32 v56, v34, v10
    v_and_b32 v57, v34, v11
    v_and_b32 v58, v35, v10
    v_and_b32 v59, v35, v11
    v_add_f32 v21, v21, v51
    v_add_f32 v21, v21, v22
    s_waitcnt vmcnt(3)
    s_lshl_b32 s30, s30, 15
    buffer_load_dwordx4 v[64:67], v2, s[20:23], s30 offen nt
    v_mfma_f32_16x16x16_bf16 v[24:27], v[112:113], v[52:53], v[24:27]
    v_mfma_f32_16x16x16_bf16 v[28:31], v[114:115], v[52:53], v[28:31]
    s_waitcnt vmcnt(3)
    buffer_load_dwordx4 v[68:71], v3, s[20:23], s30 offen nt
    v_mfma_f32_16x16x16_bf16 v[24:27], v[116:117], v[54:55], v[24:27]
    v_mfma_f32_16x16x16_bf16 v[28:31], v[118:119], v[54:55], v[28:31]
    s_waitcnt vmcnt(3)
    buffer_load_dwordx4 v[72:75], v4, s[20:23], s30 offen nt
    v_mfma_f32_16x16x16_bf16 v[24:27], v[120:121], v[56:57], v[24:27]
    v_mfma_f32_16x16x16_bf16 v[28:31], v[122:123], v[56:57], v[28:31]
    s_waitcnt vmcnt(3)
    buffer_load_dwordx4 v[76:79], v5, s[20:23], s30 offen nt
    v_mfma_f32_16x16x16_bf16 v[24:27], v[124:125], v[58:59], v[24:27]
    v_mfma_f32_16x16x16_bf16 v[28:31], v[126:127], v[58:59], v[28:31]
L_it_6:
    s_waitcnt vmcnt(3)
    buffer_load_dwordx4 v[80:83], v6, s[24:27], s30 offen nt
    v_mfma_f32_16x16x32_bf16 v[32:35], v[64:67], v[12:15], 0
    s_waitcnt vmcnt(3)
    buffer_load_dwordx4 v[84:87], v7, s[24:27], s30 offen nt
    v_mfma_f32_16x16x32_bf16 v[36:39], v[68:71], v[12:15], 0
    s_waitcnt vmcnt(3)
    buffer_load_dwordx4 v[88:91], v8, s[24:27], s30 offen nt
    v_mfma_f32_16x16x32_bf16 v[40:43], v[72:75], v[12:15], 0
    s_waitcnt vmcnt(3)
    buffer_load_dwordx4 v[92:95], v9, s[24:27], s30 offen nt
    v_mfma_f32_16x16x32_bf16 v[44:47], v[76:79], v[12:15], 0
    s_mul_i32 s43, s45, 32
    s_sub_i32 s43, s42, s43
    v_mul_f32_dpp v48, v32, v16 quad_perm:[0,0,0,0] row_mask:0xf bank_mask:0xf
    v_fmac_f32_dpp v48, v33, v16 quad_perm:[1,1,1,1] row_mask:0xf bank_mask:0xf
    v_fmac_f32_dpp v48, v34, v16 quad_perm:[2,2,2,2] row_mask:0xf bank_mask:0xf
    v_fmac_f32_dpp v48, v35, v16 quad_perm:[3,3,3,3] row_mask:0xf bank_mask:0xf
    v_mul_f32_dpp v49, v36, v16 quad_perm:[0,0,0,0] row_mask:0xf bank_mask:0xf
    v_fmac_f32_dpp v49, v37, v16 quad_perm:[1,1,1,1] row_mask:0xf bank_mask:0xf
    v_fmac_f32_dpp v49, v38, v16 quad_perm:[2,2,2,2] row_mask:0xf bank_mask:0xf
    v_fmac_f32_dpp v49, v39, v16 quad_perm:[3,3,3,3] row_mask:0xf bank_mask:0xf
    v_mul_f32_dpp v50, v40, v16 quad_perm:[0,0,0,0] row_mask:0xf bank_mask:0xf
    v_fmac_f32_dpp v50, v41, v16 quad_perm:[1,1,1,1] row_mask:0xf bank_mask:0xf
    v_fmac_f32_dpp v50, v42, v16 quad_perm:[2,2,2,2] row_mask:0xf bank_mask:0xf
    v_fmac_f32_dpp v50, v43, v16 quad_perm:[3,3,3,3] row_mask:0xf bank_mask:0xf
    v_mul_f32_dpp v51, v44, v16 quad_perm:[0,0,0,0] row_mask:0xf bank_mask:0xf
    v_fmac_f32_dpp v51, v45, v16 quad_perm:[1,1,1,1] row_mask:0xf bank_mask:0xf
    v_fmac_f32_dpp v51, v46, v16 quad_perm:[2,2,2,2] row_mask:0xf bank_mask:0xf
    v_fmac_f32_dpp v51, v47, v16 quad_perm:[3,3,3,3] row_mask:0xf bank_mask:0xf
    s_cmp_ge_i32 s43, 16
    s_cbranch_scc1 L_nomask_6
    s_sub_i32 s44, s43, 0
    v_cmp_gt_i32_e64 s[46:47], s44, v18
    s_sub_i32 s44, s43, 4
    v_cmp_gt_i32_e64 s[48:49], s44, v18
    s_sub_i32 s44, s43, 8
    v_cmp_gt_i32_e64 s[50:51], s44, v18
    s_sub_i32 s44, s43, 12
    v_cmp_gt_i32_e64 s[52:53], s44, v18
    v_cndmask_b32_e64 v48, v17, v48, s[46:47]
    v_cndmask_b32_e64 v49, v17, v49, s[48:49]
    v_cndmask_b32_e64 v50, v17, v50, s[50:51]
    v_cndmask_b32_e64 v51, v17, v51, s[52:53]
L_nomask_6:
    v_max3_f32 v22, v48, v49, v50
    v_max3_f32 v22, v22, v51, v20
    v_mov_b32 v23, v22
    s_nop 1
    v_permlane32_swap_b32 v22, v23
    v_max_f32 v22, v22, v23
    v_mov_b32 v23, v22
    s_nop 1
    v_permlane16_swap_b32 v22, v23
    v_max_f32 v22, v22, v23
    v_sub_f32 v19, v20, v22
    v_sub_f32 v48, v48, v22
    v_sub_f32 v49, v49, v22
    v_sub_f32 v50, v50, v22
    v_sub_f32 v51, v51, v22
    v_exp_f32 v19, v19
    v_exp_f32 v48, v48
    v_exp_f32 v49, v49
    v_exp_f32 v50, v50
    v_exp_f32 v51, v51
    v_mov_b32 v20, v22
    v_mul_f32 v24, v24, v19
    v_mul_f32 v25, v25, v19
    v_mul_f32 v26, v26, v19
    v_mul_f32 v27, v27, v19
    v_mul_f32 v28, v28, v19
    v_mul_f32 v29, v29, v19
    v_mul_f32 v30, v30, v19
    v_mul_f32 v31, v31, v19
    v_cvt_pk_bf16_f32 v32, v48, v48
    v_cvt_pk_bf16_f32 v33, v49, v49
    v_cvt_pk_bf16_f32 v34, v50, v50
    v_cvt_pk_bf16_f32 v35, v51, v51
    v_fma_f32 v21, v21, v19, v48
    v_add_f32 v22, v49, v50
    v_and_b32 v52, v32, v10
    v_and_b32 v53, v32, v11
    v_and_b32 v54, v33, v10
    v_and_b32 v55, v33, v11
    v_and_b32 v56, v34, v10
    v_and_b32 v57, v34, v11
    v_and_b32 v58, v35, v10
    v_and_b32 v59, v35, v11
    v_add_f32 v21, v21, v51
    v_add_f32 v21, v21, v22
    s_waitcnt vmcnt(3)
    s_lshl_b32 s29, s29, 15
    buffer_load_dwordx4 v[96:99], v2, s[20:23], s29 offen nt
    v_mfma_f32_16x16x16_bf16 v[24:27], v[80:81], v[52:53], v[24:27]
    v_mfma_f32_16x16x16_bf16 v[28:31], v[82:83], v[52:53], v[28:31]
    s_waitcnt vmcnt(3)
    buffer_load_dwordx4 v[100:103], v3, s[20:23], s29 offen nt
    v_mfma_f32_16x16x16_bf16 v[24:27], v[84:85], v[54:55], v[24:27]
    v_mfma_f32_16x16x16_bf16 v[28:31], v[86:87], v[54:55], v[28:31]
    s_waitcnt vmcnt(3)
    buffer_load_dwordx4 v[104:107], v4, s[20:23], s29 offen nt
    v_mfma_f32_16x16x16_bf16 v[24:27], v[88:89], v[56:57], v[24:27]
    v_mfma_f32_16x16x16_bf16 v[28:31], v[90:91], v[56:57], v[28:31]
    s_waitcnt vmcnt(3)
    buffer_load_dwordx4 v[108:111], v5, s[20:23], s29 offen nt
    v_mfma_f32_16x16x16_bf16 v[24:27], v[92:93], v[58:59], v[24:27]
    v_mfma_f32_16x16x16_bf16 v[28:31], v[94:95], v[58:59], v[28:31]
L_it_7:
    s_waitcnt vmcnt(3)
    buffer_load_dwordx4 v[112:115], v6, s[24:27], s29 offen nt
    v_mfma_f32_16x16x32_bf16 v[32:35], v[96:99], v[12:15], 0
    s_waitcnt vmcnt(3)
    buffer_load_dwordx4 v[116:119], v7, s[24:27], s29 offen nt
    v_mfma_f32_16x16x32_bf16 v[36:39], v[100:103], v[12:15], 0
    s_waitcnt vmcnt(3)
    buffer_load_dwordx4 v[120:123], v8, s[24:27], s29 offen nt
    v_mfma_f32_16x16x32_bf16 v[40:43], v[104:107], v[12:15], 0
    s_waitcnt vmcnt(3)
    buffer_load_dwordx4 v[124:127], v9, s[24:27], s29 offen nt
    v_mfma_f32_16x16x32_bf16 v[44:47], v[108:111], v[12:15], 0
    s_mul_i32 s43, s45, 16
    s_sub_i32 s43, s42, s43
    v_mul_f32_dpp v48, v32, v16 quad_perm:[0,0,0,0] row_mask:0xf bank_mask:0xf
    v_fmac_f32_dpp v48, v33, v16 quad_perm:[1,1,1,1] row_mask:0xf bank_mask:0xf
    v_fmac_f32_dpp v48, v34, v16 quad_perm:[2,2,2,2] row_mask:0xf bank_mask:0xf
    v_fmac_f32_dpp v48, v35, v16 quad_perm:[3,3,3,3] row_mask:0xf bank_mask:0xf
    v_mul_f32_dpp v49, v36, v16 quad_perm:[0,0,0,0] row_mask:0xf bank_mask:0xf
    v_fmac_f32_dpp v49, v37, v16 quad_perm:[1,1,1,1] row_mask:0xf bank_mask:0xf
    v_fmac_f32_dpp v49, v38, v16 quad_perm:[2,2,2,2] row_mask:0xf bank_mask:0xf
    v_fmac_f32_dpp v49, v39, v16 quad_perm:[3,3,3,3] row_mask:0xf bank_mask:0xf
    v_mul_f32_dpp v50, v40, v16 quad_perm:[0,0,0,0] row_mask:0xf bank_mask:0xf
    v_fmac_f32_dpp v50, v41, v16 quad_perm:[1,1,1,1] row_mask:0xf bank_mask:0xf
    v_fmac_f32_dpp v50, v42, v16 quad_perm:[2,2,2,2] row_mask:0xf bank_mask:0xf
    v_fmac_f32_dpp v50, v43, v16 quad_perm:[3,3,3,3] row_mask:0xf bank_mask:0xf
    v_mul_f32_dpp v51, v44, v16 quad_perm:[0,0,0,0] row_mask:0xf bank_mask:0xf
    v_fmac_f32_dpp v51, v45, v16 quad_perm:[1,1,1,1] row_mask:0xf bank_mask:0xf
    v_fmac_f32_dpp v51, v46, v16 quad_perm:[2,2,2,2] row_mask:0xf bank_mask:0xf
    v_fmac_f32_dpp v51, v47, v16 quad_perm:[3,3,3,3] row_mask:0xf bank_mask:0xf
    s_cmp_ge_i32 s43, 16
    s_cbranch_scc1 L_nomask_7
    s_sub_i32 s44, s43, 0
    v_cmp_gt_i32_e64 s[46:47], s44, v18
    s_sub_i32 s44, s43, 4
    v_cmp_gt_i32_e64 s[48:49], s44, v18
    s_sub_i32 s44, s43, 8
    v_cmp_gt_i32_e64 s[50:51], s44, v18
    s_sub_i32 s44, s43, 12
    v_cmp_gt_i32_e64 s[52:53], s44, v18
    v_cndmask_b32_e64 v48, v17, v48, s[46:47]
    v_cndmask_b32_e64 v49, v17, v49, s[48:49]
    v_cndmask_b32_e64 v50, v17, v50, s[50:51]
    v_cndmask_b32_e64 v51, v17, v51, s[52:53]
L_nomask_7:
    v_max3_f32 v22, v48, v49, v50
    v_max3_f32 v22, v22, v51, v20
    v_mov_b32 v23, v22
    s_nop 1
    v_permlane32_swap_b32 v22, v23
    v_max_f32 v22, v22, v23
    v_mov_b32 v23, v22
    s_nop 1
    v_permlane16_swap_b32 v22, v23
    v_max_f32 v22, v22, v23
    v_sub_f32 v19, v20, v22
    v_sub_f32 v48, v48, v22
    v_sub_f32 v49, v49, v22
    v_sub_f32 v50, v50, v22
    v_sub_f32 v51, v51, v22
    v_exp_f32 v19, v19
    v_exp_f32 v48, v48
    v_exp_f32 v49, v49
    v_exp_f32 v50, v50
    v_exp_f32 v51, v51
    v_mov_b32 v20, v22
    v_mul_f32 v24, v24, v19
    v_mul_f32 v25, v25, v19
    v_mul_f32 v26, v26, v19
    v_mul_f32 v27, v27, v19
    v_mul_f32 v28, v28, v19
    v_mul_f32 v29, v29, v19
    v_mul_f32 v30, v30, v19
    v_mul_f32 v31, v31, v19
    v_cvt_pk_bf16_f32 v32, v48, v48
    v_cvt_pk_bf16_f32 v33, v49, v49
    v_cvt_pk_bf16_f32 v34, v50, v50
    v_cvt_pk_bf16_f32 v35, v51, v51
    v_fma_f32 v21, v21, v19, v48
    v_add_f32 v22, v49, v50
    v_and_b32 v52, v32, v10
    v_and_b32 v53, v32, v11
    v_and_b32 v54, v33, v10
    v_and_b32 v55, v33, v11
    v_and_b32 v56, v34, v10
    v_and_b32 v57, v34, v11
    v_and_b32 v58, v35, v10
    v_and_b32 v59, v35, v11
    v_add_f32 v21, v21, v51
    v_add_f32 v21, v21, v22
    s_waitcnt vmcnt(3)
    s_lshl_b32 s28, s28, 15
    buffer_load_dwordx4 v[64:67], v2, s[20:23], s28 offen nt
    v_mfma_f32_16x16x16_bf16 v[24:27], v[112:113], v[52:53], v[24:27]
    v_mfma_f32_16x16x16_bf16 v[28:31], v[114:115], v[52:53], v[28:31]
    s_waitcnt vmcnt(3)
    buffer_load_dwordx4 v[68:71], v3, s[20:23], s28 offen nt
    v_mfma_f32_16x16x16_bf16 v[24:27], v[116:117], v[54:55], v[24:27]
    v_mfma_f32_16x16x16_bf16 v[28:31], v[118:119], v[54:55], v[28:31]
    s_waitcnt vmcnt(3)
    buffer_load_dwordx4 v[72:75], v4, s[20:23], s28 offen nt
    v_mfma_f32_16x16x16_bf16 v[24:27], v[120:121], v[56:57], v[24:27]
    v_mfma_f32_16x16x16_bf16 v[28:31], v[122:123], v[56:57], v[28:31]
    s_waitcnt vmcnt(3)
    buffer_load_dwordx4 v[76:79], v5, s[20:23], s28 offen nt
    v_mfma_f32_16x16x16_bf16 v[24:27], v[124:125], v[58:59], v[24:27]
    v_mfma_f32_16x16x16_bf16 v[28:31], v[126:127], v[58:59], v[28:31]
L_it_8:
    s_waitcnt vmcnt(3)
    buffer_load_dwordx4 v[80:83], v6, s[24:27], s28 offen nt
    v_mfma_f32_16x16x32_bf16 v[32:35], v[64:67], v[12:15], 0
    s_waitcnt vmcnt(3)
    buffer_load_dwordx4 v[84:87], v7, s[24:27], s28 offen nt
    v_mfma_f32_16x16x32_bf16 v[36:39], v[68:71], v[12:15], 0
    s_waitcnt vmcnt(3)
    buffer_load_dwordx4 v[88:91], v8, s[24:27], s28 offen nt
    v_mfma_f32_16x16x32_bf16 v[40:43], v[72:75], v[12:15], 0
    s_waitcnt vmcnt(3)
    buffer_load_dwordx4 v[92:95], v9, s[24:27], s28 offen nt
    v_mfma_f32_16x16x32_bf16 v[44:47], v[76:79], v[12:15], 0
    s_mul_i32 s43, s45, 0
    s_sub_i32 s43, s42, s43
    v_mul_f32_dpp v48, v32, v16 quad_perm:[0,0,0,0] row_mask:0xf bank_mask:0xf
    v_fmac_f32_dpp v48, v33, v16 quad_perm:[1,1,1,1] row_mask:0xf bank_mask:0xf
    v_fmac_f32_dpp v48, v34, v16 quad_perm:[2,2,2,2] row_mask:0xf bank_mask:0xf
    v_fmac_f32_dpp v48, v35, v16 quad_perm:[3,3,3,3] row_mask:0xf bank_mask:0xf
    v_mul_f32_dpp v49, v36, v16 quad_perm:[0,0,0,0] row_mask:0xf bank_mask:0xf
    v_fmac_f32_dpp v49, v37, v16 quad_perm:[1,1,1,1] row_mask:0xf bank_mask:0xf
    v_fmac_f32_dpp v49, v38, v16 quad_perm:[2,2,2,2] row_mask:0xf bank_mask:0xf
    v_fmac_f32_dpp v49, v39, v16 quad_perm:[3,3,3,3] row_mask:0xf bank_mask:0xf
    v_mul_f32_dpp v50, v40, v16 quad_perm:[0,0,0,0] row_mask:0xf bank_mask:0xf
    v_fmac_f32_dpp v50, v41, v16 quad_perm:[1,1,1,1] row_mask:0xf bank_mask:0xf
    v_fmac_f32_dpp v50, v42, v16 quad_perm:[2,2,2,2] row_mask:0xf bank_mask:0xf
    v_fmac_f32_dpp v50, v43, v16 quad_perm:[3,3,3,3] row_mask:0xf bank_mask:0xf
    v_mul_f32_dpp v51, v44, v16 quad_perm:[0,0,0,0] row_mask:0xf bank_mask:0xf
    v_fmac_f32_dpp v51, v45, v16 quad_perm:[1,1,1,1] row_mask:0xf bank_mask:0xf
    v_fmac_f32_dpp v51, v46, v16 quad_perm:[2,2,2,2] row_mask:0xf bank_mask:0xf
    v_fmac_f32_dpp v51, v47, v16 quad_perm:[3,3,3,3] row_mask:0xf bank_mask:0xf
    s_cmp_ge_i32 s43, 16
    s_cbranch_scc1 L_nomask_8
    s_sub_i32 s44, s43, 0
    v_cmp_gt_i32_e64 s[46:47], s44, v18
    s_sub_i32 s44, s43, 4
    v_cmp_gt_i32_e64 s[48:49], s44, v18
    s_sub_i32 s44, s43, 8
    v_cmp_gt_i32_e64 s[50:51], s44, v18
    s_sub_i32 s44, s43, 12
    v_cmp_gt_i32_e64 s[52:53], s44, v18
    v_cndmask_b32_e64 v48, v17, v48, s[46:47]
    v_cndmask_b32_e64 v49, v17, v49, s[48:49]
    v_cndmask_b32_e64 v50, v17, v50, s[50:51]
    v_cndmask_b32_e64 v51, v17, v51, s[52:53]
L_nomask_8:
    v_max3_f32 v22, v48, v49, v50
    v_max3_f32 v22, v22, v51, v20
    v_mov_b32 v23, v22
    s_nop 1
    v_permlane32_swap_b32 v22, v23
    v_max_f32 v22, v22, v23
    v_mov_b32 v23, v22
    s_nop 1
    v_permlane16_swap_b32 v22, v23
    v_max_f32 v22, v22, v23
    v_sub_f32 v19, v20, v22
    v_sub_f32 v48, v48, v22
    v_sub_f32 v49, v49, v22
    v_sub_f32 v50, v50, v22
    v_sub_f32 v51, v51, v22
    v_exp_f32 v19, v19
    v_exp_f32 v48, v48
    v_exp_f32 v49, v49
    v_exp_f32 v50, v50
    v_exp_f32 v51, v51
    v_mov_b32 v20, v22
    v_mul_f32 v24, v24, v19
    v_mul_f32 v25, v25, v19
    v_mul_f32 v26, v26, v19
    v_mul_f32 v27, v27, v19
    v_mul_f32 v28, v28, v19
    v_mul_f32 v29, v29, v19
    v_mul_f32 v30, v30, v19
    v_mul_f32 v31, v31, v19
    v_cvt_pk_bf16_f32 v32, v48, v48
    v_cvt_pk_bf16_f32 v33, v49, v49
    v_cvt_pk_bf16_f32 v34, v50, v50
    v_cvt_pk_bf16_f32 v35, v51, v51
    v_fma_f32 v21, v21, v19, v48
    v_add_f32 v22, v49, v50
    v_and_b32 v52, v32, v10
    v_and_b32 v53, v32, v11
    v_and_b32 v54, v33, v10
    v_and_b32 v55, v33, v11
    v_and_b32 v56, v34, v10
    v_and_b32 v57, v34, v11
    v_and_b32 v58, v35, v10
    v_and_b32 v59, v35, v11
    v_add_f32 v21, v21, v51
    v_add_f32 v21, v21, v22
    v_mov_b32 v23, v21
    s_nop 1
    v_permlane32_swap_b32 v21, v23
    v_add_f32 v21, v21, v23
    v_mov_b32 v23, v21
    s_nop 1
    v_permlane16_swap_b32 v21, v23
    v_add_f32 v21, v21, v23
    s_waitcnt vmcnt(3)
    v_mfma_f32_16x16x16_bf16 v[24:27], v[80:81], v[52:53], v[24:27]
    v_mfma_f32_16x16x16_bf16 v[28:31], v[82:83], v[52:53], v[28:31]
    s_waitcnt vmcnt(2)
    v_mfma_f32_16x16x16_bf16 v[24:27], v[84:85], v[54:55], v[24:27]
    v_mfma_f32_16x16x16_bf16 v[28:31], v[86:87], v[54:55], v[28:31]
    s_waitcnt vmcnt(1)
    v_mfma_f32_16x16x16_bf16 v[24:27], v[88:89], v[56:57], v[24:27]
    v_mfma_f32_16x16x16_bf16 v[28:31], v[90:91], v[56:57], v[28:31]
    s_waitcnt vmcnt(0)
    v_mfma_f32_16x16x16_bf16 v[24:27], v[92:93], v[58:59], v[24:27]
    v_mfma_f32_16x16x16_bf16 v[28:31], v[94:95], v[58:59], v[28:31]
L_it_9:
    s_nop 7
    ds_write2_b32 v128, v24, v28 offset0:0 offset1:4
    ds_write2_b32 v128, v25, v29 offset0:8 offset1:12
    ds_write2_b32 v128, v26, v30 offset0:16 offset1:20
    ds_write2_b32 v128, v27, v31 offset0:24 offset1:28
    ds_write_b64 v129, v[20:21]
    s_waitcnt vmcnt(0) lgkmcnt(0)
    s_barrier
    ds_read_b128 v[96:99], v131 offset:0
    ds_read_b128 v[100:103], v131 offset:16
    ds_read_b128 v[104:107], v131 offset:32
    ds_read_b128 v[108:111], v131 offset:48
    ds_read_b128 v[64:67], v130 offset:0
    ds_read_b128 v[68:71], v130 offset:2432
    ds_read_b128 v[72:75], v130 offset:4864
    ds_read_b128 v[76:79], v130 offset:7296
    ds_read_b128 v[80:83], v130 offset:9728
    ds_read_b128 v[84:87], v130 offset:12160
    ds_read_b128 v[88:91], v130 offset:14592
    ds_read_b128 v[92:95], v130 offset:17024
    s_waitcnt lgkmcnt(8)
    v_max3_f32 v40, v96, v98, v100
    v_max3_f32 v40, v40, v102, v104
    v_max3_f32 v40, v40, v106, v108
    v_max_f32 v40, v40, v110
    v_sub_f32 v96, v96, v40
    v_sub_f32 v98, v98, v40
    v_sub_f32 v100, v100, v40
    v_sub_f32 v102, v102, v40
    v_sub_f32 v104, v104, v40
    v_sub_f32 v106, v106, v40
    v_sub_f32 v108, v108, v40
    v_sub_f32 v110, v110, v40
    v_exp_f32 v96, v96
    v_exp_f32 v98, v98
    v_exp_f32 v100, v100
    v_exp_f32 v102, v102
    v_exp_f32 v104, v104
    v_exp_f32 v106, v106
    v_exp_f32 v108, v108
    v_exp_f32 v110, v110
    v_mul_f32 v41, v96, v97
    v_fmac_f32 v41, v98, v99
    v_fmac_f32 v41, v100, v101
    v_fmac_f32 v41, v102, v103
    v_fmac_f32 v41, v104, v105
    v_fmac_f32 v41, v106, v107
    v_fmac_f32 v41, v108, v109
    v_fmac_f32 v41, v110, v111
    s_waitcnt lgkmcnt(0)
    v_mul_f32 v44, v96, v64
    v_mul_f32 v45, v96, v65
    v_mul_f32 v46, v96, v66
    v_mul_f32 v47, v96, v67
    v_fmac_f32 v44, v98, v68
    v_fmac_f32 v45, v98, v69
    v_fmac_f32 v46, v98, v70
    v_fmac_f32 v47, v98, v71
    v_fmac_f32 v44, v100, v72
    v_fmac_f32 v45, v100, v73
    v_fmac_f32 v46, v100, v74
    v_fmac_f32 v47, v100, v75
    v_fmac_f32 v44, v102, v76
    v_fmac_f32 v45, v102, v77
    v_fmac_f32 v46, v102, v78
    v_fmac_f32 v47, v102, v79
    v_fmac_f32 v44, v104, v80
    v_fmac_f32 v45, v104, v81
    v_fmac_f32 v46, v104, v82
    v_fmac_f32 v47, v104, v83
    v_fmac_f32 v44, v106, v84
    v_fmac_f32 v45, v106, v85
    v_fmac_f32 v46, v106, v86
    v_fmac_f32 v47, v106, v87
    v_fmac_f32 v44, v108, v88
    v_fmac_f32 v45, v108, v89
    v_fmac_f32 v46, v108, v90
    v_fmac_f32 v47, v108, v91
    v_fmac_f32 v44, v110, v92
    v_fmac_f32 v45, v110, v93
    v_fmac_f32 v46, v110, v94
    v_fmac_f32 v47, v110, v95
    v_cvt_pk_bf16_f32 v44, v44, v45
    v_cvt_pk_bf16_f32 v45, v46, v47
    s_mov_b64 exec, 0xffff
    global_store_dwordx2 v132, v[44:45], s[18:19] sc1
    s_mov_b64 exec, 1
    global_store_dwordx2 v133, v[40:41], s[18:19] sc1
    s_mov_b64 exec, -1
    s_mov_b32 s68, s18
    s_mov_b32 s69, s19
    s_add_u32 s43, s76, s75
    s_lshl_b32 s70, s43, 10
    s_mov_b32 s71, 0x00020000
    s_mov_b32 s80, s18
    s_mov_b32 s81, s19
    s_lshl_b32 s43, s75, 3
    s_add_u32 s82, s78, s43
    s_mov_b32 s83, 0x00020000
    v_lshl_add_u32 v42, v1, 3, s78
    v_lshrrev_b32 v38, 3, v1
    v_and_b32 v48, 7, v1
    s_lshl_b32 s43, s76, 10
    s_lshl_b32 s44, s39, 7
    s_add_u32 s43, s43, s44
    v_lshlrev_b32 v39, 10, v38
    v_lshl_add_u32 v39, v48, 4, v39
    v_add_u32 v39, s43, v39
    v_lshlrev_b32 v38, 2, v38
    s_lshl_b32 s43, s67, 10
    s_add_u32 s43, s43, s44
    v_lshlrev_b32 v43, 4, v48
    v_lshrrev_b32 v49, 4, v1
    v_lshl_add_u32 v43, v49, 2, v43
    v_add_u32 v43, s43, v43
    s_movk_i32 s72, 0x2000
    s_movk_i32 s73, 0x4000
    s_movk_i32 s74, 0x6000
    s_mov_b32 s77, 0x8000
    s_lshl_b32 s43, s67, 5
    v_mov_b32 v2, s43
    v_mov_b32 v3, 1
    v_mov_b32 v5, 0
    s_waitcnt vmcnt(0)
    s_barrier
    s_cmp_lg_u32 s39, 0
    s_cbranch_scc1 L_noat
    s_mov_b64 exec, 1
    global_atomic_add v4, v2, v3, s[16:17] sc0
    s_waitcnt vmcnt(0)
    ds_write_b32 v5, v4
    s_mov_b64 exec, -1
    s_waitcnt lgkmcnt(0)
L_noat:
    s_barrier
    ds_read_b32 v4, v5
    s_sub_u32 s44, s75, 1
    s_waitcnt lgkmcnt(0)
    v_readfirstlane_b32 s43, v4
    s_nop 0
    s_cmp_lg_u32 s43, s44
    s_cbranch_scc1 L_fin
    buffer_load_dwordx2 v[8:9], v42, s[80:83], 0 offen sc1
    buffer_load_dwordx4 v[64:67], v39, s[68:71], 0 offen sc1
    buffer_load_dwordx4 v[68:71], v39, s[68:71], s72 offen sc1
    buffer_load_dwordx4 v[72:75], v39, s[68:71], s73 offen sc1
    buffer_load_dwordx4 v[76:79], v39, s[68:71], s74 offen sc1
    buffer_load_dwordx4 v[80:83], v39, s[68:71], s77 offen sc1
    v_mov_b32 v10, 0xff7fffff
    s_waitcnt vmcnt(5)
    v_cmp_eq_f32 vcc, 0, v9
    s_nop 1
    v_cndmask_b32 v8, v8, v10, vcc
    v_mov_b32 v10, v8
    s_nop 1
    v_max_f32_dpp v10, v10, v10 row_ror:8 row_mask:0xf bank_mask:0xf
    s_nop 1
    v_max_f32_dpp v10, v10, v10 row_ror:4 row_mask:0xf bank_mask:0xf
    s_nop 1
    v_max_f32_dpp v10, v10, v10 row_ror:2 row_mask:0xf bank_mask:0xf
    s_nop 1
    v_max_f32_dpp v10, v10, v10 row_ror:1 row_mask:0xf bank_mask:0xf
    v_mov_b32 v11, v10
    s_nop 1
    v_permlane32_swap_b32 v10, v11
    v_max_f32 v10, v10, v11
    v_mov_b32 v11, v10
    s_nop 1
    v_permlane16_swap_b32 v10, v11
    v_max_f32 v10, v10, v11
    v_sub_f32 v8, v8, v10
    v_exp_f32 v8, v8
    s_nop 0
    v_mul_f32 v9, v8, v9
    ds_bpermute_b32 v12, v38, v8 offset:0
    ds_bpermute_b32 v13, v38, v8 offset:32
    ds_bpermute_b32 v14, v38, v8 offset:64
    ds_bpermute_b32 v15, v38, v8 offset:96
    ds_bpermute_b32 v16, v38, v8 offset:128
    v_add_f32_dpp v9, v9, v9 row_ror:8 row_mask:0xf bank_mask:0xf
    s_nop 1
    v_add_f32_dpp v9, v9, v9 row_ror:4 row_mask:0xf bank_mask:0xf
    s_nop 1
    v_add_f32_dpp v9, v9, v9 row_ror:2 row_mask:0xf bank_mask:0xf
    s_nop 1
    v_add_f32_dpp v9, v9, v9 row_ror:1 row_mask:0xf bank_mask:0xf
    v_mov_b32 v11, v9
    s_nop 1
    v_permlane32_swap_b32 v9, v11
    v_add_f32 v9, v9, v11
    v_mov_b32 v11, v9
    s_nop 1
    v_permlane16_swap_b32 v9, v11
    v_add_f32 v9, v9, v11
    v_rcp_f32 v9, v9
    s_mov_b32 s43, 0xffff0000
    s_waitcnt vmcnt(0) lgkmcnt(0)
    v_lshlrev_b32 v30, 16, v64
    v_and_b32 v31, s43, v64
    v_lshlrev_b32 v32, 16, v65
    v_and_b32 v33, s43, v65
    v_lshlrev_b32 v34, 16, v66
    v_and_b32 v35, s43, v66
    v_lshlrev_b32 v36, 16, v67
    v_and_b32 v37, s43, v67
    v_mul_f32 v20, v12, v30
    v_mul_f32 v21, v12, v31
    v_mul_f32 v22, v12, v32
    v_mul_f32 v23, v12, v33
    v_mul_f32 v24, v12, v34
    v_mul_f32 v25, v12, v35
    v_mul_f32 v26, v12, v36
    v_mul_f32 v27, v12, v37
    v_lshlrev_b32 v30, 16, v68
    v_and_b32 v31, s43, v68
    v_lshlrev_b32 v32, 16, v69
    v_and_b32 v33, s43, v69
    v_lshlrev_b32 v34, 16, v70
    v_and_b32 v35, s43, v70
    v_lshlrev_b32 v36, 16, v71
    v_and_b32 v37, s43, v71
    v_fmac_f32 v20, v13, v30
    v_fmac_f32 v21, v13, v31
    v_fmac_f32 v22, v13, v32
    v_fmac_f32 v23, v13, v33
    v_fmac_f32 v24, v13, v34
    v_fmac_f32 v25, v13, v35
    v_fmac_f32 v26, v13, v36
    v_fmac_f32 v27, v13, v37
    v_lshlrev_b32 v30, 16, v72
    v_and_b32 v31, s43, v72
    v_lshlrev_b32 v32, 16, v73
    v_and_b32 v33, s43, v73
    v_lshlrev_b32 v34, 16, v74
    v_and_b32 v35, s43, v74
    v_lshlrev_b32 v36, 16, v75
    v_and_b32 v37, s43, v75
    v_fmac_f32 v20, v14, v30
    v_fmac_f32 v21, v14, v31
    v_fmac_f32 v22, v14, v32
    v_fmac_f32 v23, v14, v33
    v_fmac_f32 v24, v14, v34
    v_fmac_f32 v25, v14, v35
    v_fmac_f32 v26, v14, v36
    v_fmac_f32 v27, v14, v37
    v_lshlrev_b32 v30, 16, v76
    v_and_b32 v31, s43, v76
    v_lshlrev_b32 v32, 16, v77
    v_and_b32 v33, s43, v77
    v_lshlrev_b32 v34, 16, v78
    v_and_b32 v35, s43, v78
    v_lshlrev_b32 v36, 16, v79
    v_and_b32 v37, s43, v79
    v_fmac_f32 v20, v15, v30
    v_fmac_f32 v21, v15, v31
    v_fmac_f32 v22, v15, v32
    v_fmac_f32 v23, v15, v33
    v_fmac_f32 v24, v15, v34
    v_fmac_f32 v25, v15, v35
    v_fmac_f32 v26, v15, v36
    v_fmac_f32 v27, v15, v37
    v_lshlrev_b32 v30, 16, v80
    v_and_b32 v31, s43, v80
    v_lshlrev_b32 v32, 16, v81
    v_and_b32 v33, s43, v81
    v_lshlrev_b32 v34, 16, v82
    v_and_b32 v35, s43, v82
    v_lshlrev_b32 v36, 16, v83
    v_and_b32 v37, s43, v83
    v_fmac_f32 v20, v16, v30
    v_fmac_f32 v21, v16, v31
    v_fmac_f32 v22, v16, v32
    v_fmac_f32 v23, v16, v33
    v_fmac_f32 v24, v16, v34
    v_fmac_f32 v25, v16, v35
    v_fmac_f32 v26, v16, v36
    v_fmac_f32 v27, v16, v37
    v_permlane32_swap_b32 v20, v24
    v_permlane32_swap_b32 v21, v25
    v_permlane32_swap_b32 v22, v26
    v_permlane32_swap_b32 v23, v27
    v_add_f32 v20, v20, v24
    v_add_f32 v21, v21, v25
    v_add_f32 v22, v22, v26
    v_add_f32 v23, v23, v27
    s_nop 0
    v_permlane16_swap_b32 v20, v22
    v_permlane16_swap_b32 v21, v23
    v_add_f32 v20, v20, v22
    v_add_f32 v21, v21, v23
    s_nop 0
    v_add_f32_dpp v20, v20, v20 row_ror:8 row_mask:0xf bank_mask:0xf
    v_add_f32_dpp v21, v21, v21 row_ror:8 row_mask:0xf bank_mask:0xf
    v_mul_f32 v20, v20, v9
    v_mul_f32 v21, v21, v9
    v_cvt_pk_bf16_f32 v16, v20, v21
    s_mov_b32 exec_lo, 0x00ff00ff
    s_mov_b32 exec_hi, 0x00ff00ff
    global_store_dword v43, v16, s[14:15]
L_fin:
L_end:
    s_endpgm

.section .rodata,"a"
.p2align 6
.amdhsa_kernel standalone__paged_block_table_kv_pagedattention__decode_kernel
  .amdhsa_next_free_vgpr 136
  .amdhsa_next_free_sgpr 100
  .amdhsa_accum_offset 136
  .amdhsa_group_segment_fixed_size 0
  .amdhsa_kernarg_size 64
  .amdhsa_user_sgpr_count 2
  .amdhsa_user_sgpr_kernarg_segment_ptr 1
  .amdhsa_system_sgpr_workgroup_id_x 1
.end_amdhsa_kernel
```
